```python
import torch

def _softmax(x, axis=-1):
    return torch.softmax(x, dim=axis)
def _gelu(x):
    return torch.nn.functional.gelu(x, approximate="tanh")
def _silu(x):
    return torch.nn.functional.silu(x)
def _sigmoid(x):
    return torch.sigmoid(x)
def _layernorm(x, axis=-1, eps=1e-5):
    m = x.mean(dim=axis, keepdim=True)
    v = x.var(dim=axis, keepdim=True, unbiased=False)
    return (x - m) / torch.sqrt(v + eps)
def _scatter_add(tgt, idx, src, axis=0):
    return tgt.clone().index_add_(axis, idx, src)
def _segment_sum(src, seg, n):
    out = torch.zeros((n,) + src.shape[1:], dtype=src.dtype)
    return out.index_add_(0, seg, src)
def _pad(x, pw):
    flat = tuple(v for pair in reversed(pw) for v in pair)
    return torch.nn.functional.pad(x, flat)

kernel_name = 'gated_mix__sliding_block_cached__sliding_block_cached__decode'

def setup_inputs():

    _w = (lambda a: (lambda t: t.to(torch.bfloat16) if t.is_floating_point() else t)(torch.as_tensor(a)))
    def _A_setup():
        B, Sq, D = 1, 1, 512
        Hq, Hkv, Sk, Dh = 32, 8, 65536, 128
        assert Hq % Hkv == 0, (Hq, Hkv)
        return {
            "x": _w((lambda *s: torch.randn(*s, dtype=torch.bfloat16) * 0.05)(B, Sq, D)),
            "k_cache": _w((lambda *s: torch.randn(*s, dtype=torch.bfloat16) * 6.4)(B, Hkv, Sk, Dh)),
            "v_cache": _w((lambda *s: torch.randn(*s, dtype=torch.bfloat16) * 0.05)(B, Hkv, Sk, Dh)),
            "wq": _w((lambda *s: torch.randn(*s, dtype=torch.bfloat16) * 6.4)(D, Hq * Dh) * (D ** -0.5)),
            "wo": _w((lambda *s: torch.randn(*s, dtype=torch.bfloat16) * 0.05)(Hq * Dh, D) * ((Hq * Dh) ** -0.5)),
        }
    _A_in = _A_setup()

    def _B_setup():
        B, Sq, D = 1, 1, 512
        Hq, Hkv, Sk, Dh = 32, 8, 65536, 128
        assert Hq % Hkv == 0, (Hq, Hkv)
        return {
            "x": _w((lambda *s: torch.randn(*s, dtype=torch.bfloat16) * 0.05)(B, Sq, D)),
            "k_cache": _w((lambda *s: torch.randn(*s, dtype=torch.bfloat16) * 6.4)(B, Hkv, Sk, Dh)),
            "v_cache": _w((lambda *s: torch.randn(*s, dtype=torch.bfloat16) * 0.05)(B, Hkv, Sk, Dh)),
            "wq": _w((lambda *s: torch.randn(*s, dtype=torch.bfloat16) * 6.4)(D, Hq * Dh) * (D ** -0.5)),
            "wo": _w((lambda *s: torch.randn(*s, dtype=torch.bfloat16) * 0.05)(Hq * Dh, D) * ((Hq * Dh) ** -0.5)),
        }
    _B_in = _B_setup()

    return {
        "A_x": _A_in["x"],
        "A_k_cache": _A_in["k_cache"],
        "A_v_cache": _A_in["v_cache"],
        "A_wq": _A_in["wq"],
        "A_wo": _A_in["wo"],
        "B_x": _B_in["x"],
        "B_k_cache": _B_in["k_cache"],
        "B_v_cache": _B_in["v_cache"],
        "B_wq": _B_in["wq"],
        "B_wo": _B_in["wo"],
        "gate_w": _w((lambda *s: torch.randn(*s, dtype=torch.bfloat16) * 0.05)(512) * 16.0),
    }

def reference(A_x, A_k_cache, A_v_cache, A_wq, A_wo, B_x, B_k_cache, B_v_cache, B_wq, B_wo, gate_w):
    def _A_ref(x, k_cache, v_cache, wq, wo):
        B, Sq, D = x.shape
        Hq, Dh = 32, 128
        Hkv, Sk = k_cache.shape[1], k_cache.shape[2]
        W = min(4096, max(256, Sk // 4))
        rep = Hq // Hkv
        q = (lambda x, *d: x.permute(*d))((x @ wq).reshape(B, Sq, Hq, Dh), 0, 2, 1, 3)
        k = (lambda x, n, axis: torch.repeat_interleave(x, n, dim=axis))(k_cache[:, :, Sk - W:, :], rep, axis=1)
        v = (lambda x, n, axis: torch.repeat_interleave(x, n, dim=axis))(v_cache[:, :, Sk - W:, :], rep, axis=1)
        scores = torch.einsum("bhqd,bhkd->bhqk", q, k) * (Dh ** -0.5)
        p = _softmax(scores, axis=-1)
        o = torch.einsum("bhqk,bhkd->bhqd", p, v)
        return (lambda x, *d: x.permute(*d))(o, 0, 2, 1, 3).reshape(B, Sq, Hq * Dh) @ wo

    def _B_ref(x, k_cache, v_cache, wq, wo):
        B, Sq, D = x.shape
        Hq, Dh = 32, 128
        Hkv, Sk = k_cache.shape[1], k_cache.shape[2]
        W = min(4096, max(256, Sk // 4))
        rep = Hq // Hkv
        q = (lambda x, *d: x.permute(*d))((x @ wq).reshape(B, Sq, Hq, Dh), 0, 2, 1, 3)
        k = (lambda x, n, axis: torch.repeat_interleave(x, n, dim=axis))(k_cache[:, :, Sk - W:, :], rep, axis=1)
        v = (lambda x, n, axis: torch.repeat_interleave(x, n, dim=axis))(v_cache[:, :, Sk - W:, :], rep, axis=1)
        scores = torch.einsum("bhqd,bhkd->bhqk", q, k) * (Dh ** -0.5)
        p = _softmax(scores, axis=-1)
        o = torch.einsum("bhqk,bhkd->bhqd", p, v)
        return (lambda x, *d: x.permute(*d))(o, 0, 2, 1, 3).reshape(B, Sq, Hq * Dh) @ wo

    x = A_x
    g = _sigmoid((x * gate_w).sum(-1, keepdims=True))
    a = _A_ref(x, A_k_cache, A_v_cache, A_wq, A_wo)
    b = _B_ref(x, B_k_cache, B_v_cache, B_wq, B_wo)
    return g * a + (1 - g) * b
```

```asm
; @launch grid=(256,1,1) block=(768,1,1) lds=16384
.amdgcn_target "amdgcn-amd-amdhsa--gfx950"
.text
.globl gated_mix__sliding_block_cached__sliding_block_cached__decode_kernel
.p2align 12
.fill 832, 4, 0xBF800000
.p2align 8
.type gated_mix__sliding_block_cached__sliding_block_cached__decode_kernel,@function
gated_mix__sliding_block_cached__sliding_block_cached__decode_kernel:
    s_and_b32 s8, s2, 8
    s_mul_i32 s8, s8, 5
    s_add_u32 s8, s0, s8
    s_addc_u32 s9, s1, 0
    s_load_dwordx8 s[12:19], s[8:9], 8
    s_load_dwordx2 s[20:21], s[0:1], 0
    s_load_dwordx8 s[24:31], s[0:1], 80
    s_cmp_ge_u32 s2, 256
    s_cbranch_scc1 L_end
    v_lshrrev_b32 v2, 6, v0
    v_and_b32 v1, 63, v0
    v_readfirstlane_b32 s7, v2
    s_and_b32 s3, s2, 15
    s_lshr_b32 s4, s2, 4
    s_and_b32 s5, s2, 7
    s_lshl_b32 s10, s3, 4
    s_add_u32 s10, s10, s4
    s_and_b32 s6, s7, 3
    s_cmp_lt_u32 s7, 8
    s_cbranch_scc1 L_touch_ret
    s_cmp_eq_u32 s7, 8
    s_cbranch_scc1 L_stub_0
    s_cmp_eq_u32 s7, 9
    s_cbranch_scc1 L_stub_1
    s_cmp_eq_u32 s7, 10
    s_cbranch_scc1 L_stub_2
    s_branch L_stub_3
L_touch_ret:
    s_lshr_b32 s7, s7, 2
    s_mov_b32 s42, 0x200000
    s_lshl_b32 s8, s6, 2
    v_mov_b32 v3, 0
    v_mov_b32 v7, 1
    v_lshlrev_b32 v6, 4, v1
    v_mov_b32 v0, s8
    s_cmp_lg_u32 s7, 0
    s_cbranch_scc1 L_notQ
    s_setprio 3
    v_lshrrev_b32 v2, 3, v1
    v_and_b32 v5, 7, v1
    v_lshlrev_b32 v4, 16, v2
    v_lshl_add_u32 v4, v5, 4, v4
    v_lshlrev_b32 v5, 4, v2
    s_and_b32 s22, s4, 1
    s_lshl_b32 s22, s22, 2
    s_add_u32 s22, s22, s6
    s_lshl_b32 s23, s22, 19
    s_lshl_b32 s22, s22, 7
    s_lshl_b32 s8, s5, 10
    s_add_u32 s23, s23, s8
    s_lshr_b32 s8, s4, 1
    s_lshl_b32 s8, s8, 7
    s_add_u32 s23, s23, s8
    s_movk_i32 s9, 0x2000
    s_waitcnt lgkmcnt(0)
    s_add_u32 s34, s20, s22
    s_addc_u32 s35, s21, 0
    s_add_u32 s16, s16, s23
    s_addc_u32 s17, s17, 0
    global_load_dwordx4 v[12:15], v5, s[34:35]
    global_load_dwordx4 v[16:19], v4, s[16:17] nt
    v_add_u32 v4, s9, v4
    global_load_dwordx4 v[20:23], v4, s[16:17] nt
    v_add_u32 v4, s9, v4
    global_load_dwordx4 v[24:27], v4, s[16:17] nt
    v_add_u32 v4, s9, v4
    global_load_dwordx4 v[28:31], v4, s[16:17] nt
    v_add_u32 v4, s9, v4
    global_load_dwordx4 v[32:35], v4, s[16:17] nt
    v_add_u32 v4, s9, v4
    global_load_dwordx4 v[36:39], v4, s[16:17] nt
    v_add_u32 v4, s9, v4
    global_load_dwordx4 v[40:43], v4, s[16:17] nt
    v_add_u32 v4, s9, v4
    global_load_dwordx4 v[44:47], v4, s[16:17] nt
    s_load_dword s11, s[30:31], 0
    s_barrier
    s_branch L_Q2
L_notQ:
    v_mov_b32 v4, 0xff800000
    v_cmp_gt_u32 vcc, 32, v1
    v_lshlrev_b32 v5, 2, v1
    s_lshl_b32 s22, s5, 24
    v_cndmask_b32 v4, v4, v3, vcc
    ds_write_b32 v5, v4
    s_lshl_b32 s9, s4, 12
    s_lshl_b32 s23, s6, 10
    s_add_u32 s9, s9, s23
    s_add_u32 s22, s22, 15728640
    s_mov_b32 s44, 0x11111111
    s_mov_b32 s45, 0x11111111
    s_lshl_b64 s[46:47], s[44:45], 1
    s_lshl_b64 s[48:49], s[44:45], 2
    s_lshl_b64 s[50:51], s[44:45], 3
    s_cmp_lg_u32 s7, 2
    s_cbranch_scc1 L_K0
    s_setprio 1
    s_lshl_b32 s8, s3, 14
    s_lshl_b32 s23, s4, 8
    s_add_u32 s8, s8, s23
    s_add_u32 s8, s8, 524288
    v_lshrrev_b32 v2, 4, v1
    v_and_b32 v4, 15, v1
    v_lshlrev_b32 v4, 4, v4
    v_lshl_add_u32 v4, v2, 12, v4
    v_lshrrev_b32 v2, 4, v1
    v_mov_b32 v8, -1
    v_mov_b32 v9, -1
    v_mov_b32 v10, -1
    v_mov_b32 v11, -1
    s_waitcnt lgkmcnt(0)
    s_add_u32 s36, s30, s8
    s_addc_u32 s37, s31, 0
    s_add_u32 s14, s14, s22
    s_addc_u32 s15, s15, 0
    s_load_dword s11, s[30:31], 0
    s_cmp_lg_u32 s6, 0
    s_cbranch_scc1 L_V1
    global_store_dwordx4 v4, v[8:11], s[36:37]
    s_and_b32 s8, s4, 3
    s_lshl_b32 s8, s8, 16
    s_lshl_b32 s23, s10, 7
    s_and_b32 s23, s23, 0x1e00
    s_add_u32 s8, s8, s23
    s_lshr_b32 s23, s10, 6
    s_lshl_b32 s23, s23, 14
    s_add_u32 s8, s8, s23
    s_add_u32 s8, s8, 1310720
    s_add_u32 s40, s30, s8
    s_addc_u32 s41, s31, 0
    v_and_b32 v12, 0x1f0, v6
    v_lshrrev_b32 v13, 5, v1
    v_lshl_add_u32 v12, v13, 13, v12
    global_load_dwordx4 v[12:15], v12, s[40:41]
L_V1:
    s_barrier
    s_cmp_eq_u32 s6, 0
    s_cbranch_scc1 L_stub_4
    s_cmp_eq_u32 s6, 1
    s_cbranch_scc1 L_stub_5
    s_cmp_eq_u32 s6, 2
    s_cbranch_scc1 L_stub_6
    s_branch L_stub_7
L_K0:
    s_setprio 2
    v_bfe_u32 v8, v1, 2, 2
    v_lshlrev_b32 v4, 8, v8
    v_lshrrev_b32 v9, 4, v1
    v_lshl_add_u32 v4, v9, 6, v4
    v_and_b32 v10, 3, v1
    v_lshl_add_u32 v4, v10, 4, v4
    v_add_u32 v11, s9, v4
    s_waitcnt lgkmcnt(0)
    s_add_u32 s34, s12, s22
    s_addc_u32 s35, s13, 0
    s_barrier
    s_load_dword s11, s[30:31], 0
    v_xor_b32 v5, 0, v11
    v_xor_b32 v12, 69632, v11
    global_load_dwordx4 v[16:19], v5, s[34:35] nt
    global_load_dwordx4 v[20:23], v12, s[34:35] nt
    v_xor_b32 v5, 139264, v11
    v_xor_b32 v12, 208896, v11
Lspin_5:
    ds_read_b32 v2, v0 offset:64
    s_sub_u32 s42, s42, 1
    s_cbranch_scc1 L_end
    s_waitcnt lgkmcnt(0)
    v_cmp_gt_u32 vcc, 6, v2
    s_cbranch_vccnz Lspin_5
    global_load_dwordx4 v[24:27], v5, s[34:35] nt
    global_load_dwordx4 v[28:31], v12, s[34:35] nt
    v_xor_b32 v5, 278528, v11
    v_xor_b32 v12, 348160, v11
Lspin_6:
    ds_read_b32 v2, v0 offset:64
    s_sub_u32 s42, s42, 1
    s_cbranch_scc1 L_end
    s_waitcnt lgkmcnt(0)
    v_cmp_gt_u32 vcc, 8, v2
    s_cbranch_vccnz Lspin_6
    global_load_dwordx4 v[32:35], v5, s[34:35] nt
    global_load_dwordx4 v[36:39], v12, s[34:35] nt
    v_xor_b32 v5, 417792, v11
    v_xor_b32 v12, 487424, v11
    s_waitcnt vmcnt(4)
    global_load_dwordx4 v[40:43], v5, s[34:35] nt
    global_load_dwordx4 v[44:47], v12, s[34:35] nt
    v_xor_b32 v5, 557056, v11
    v_xor_b32 v12, 626688, v11
    s_waitcnt vmcnt(4)
    global_load_dwordx4 v[48:51], v5, s[34:35] nt
    global_load_dwordx4 v[52:55], v12, s[34:35] nt
    v_xor_b32 v5, 696320, v11
    v_xor_b32 v12, 765952, v11
    s_waitcnt vmcnt(4)
    global_load_dwordx4 v[56:59], v5, s[34:35] nt
    global_load_dwordx4 v[60:63], v12, s[34:35] nt
    v_xor_b32 v5, 835584, v11
    v_xor_b32 v12, 905216, v11
    s_waitcnt vmcnt(4)
    global_load_dwordx4 v[64:67], v5, s[34:35] nt
    global_load_dwordx4 v[68:71], v12, s[34:35] nt
    v_xor_b32 v5, 974848, v11
    v_xor_b32 v12, 1044480, v11
    s_waitcnt vmcnt(4)
    global_load_dwordx4 v[72:75], v5, s[34:35] nt
    global_load_dwordx4 v[76:79], v12, s[34:35] nt
    v_lshlrev_b32 v11, 2, v8
    v_lshrrev_b32 v2, 1, v10
    v_lshlrev_b32 v5, 8, v2
    v_lshl_add_u32 v5, v9, 6, v5
    v_lshl_add_u32 v5, v8, 4, v5
    v_and_b32 v2, 1, v10
    v_lshl_add_u32 v5, v2, 3, v5
    s_lshl_b32 s8, s6, 9
    v_add_u32 v5, s8, v5
    v_lshlrev_b32 v100, 6, v8
    v_lshl_add_u32 v100, v9, 2, v100
    s_lshl_b32 s8, s6, 4
    v_add_u32 v100, s8, v100
    s_branch L_stubskip_0
L_stub_0:
    s_branch L_touch_ret
L_stubskip_0:
    s_lshl_b32 s8, s10, 7
    s_add_u32 s8, s8, 1048576
    s_add_u32 s36, s30, s8
    s_addc_u32 s37, s31, 0
    s_movk_i32 s54, 60
    s_mov_b32 s43, 0
    s_waitcnt vmcnt(4)
    v_mov_b32 v2, 12
    ds_write_b32 v0, v2 offset:80
    s_waitcnt vmcnt(2)
    v_mov_b32 v2, 14
    ds_write_b32 v0, v2 offset:80
    s_waitcnt vmcnt(0)
    v_mov_b32 v2, 16
    ds_write_b32 v0, v2 offset:80
    s_branch L_c2
L_Q2:
    v_and_b32 v2, 1, v1
    v_lshlrev_b32 v2, 4, v2
    v_mov_b32 v4, 0xffff
    v_lshlrev_b32 v4, v2, v4
    v_bfe_u32 v2, v1, 1, 2
    s_mov_b32 s52, 0x01000100
    s_mov_b32 s53, 0x03020302
    s_getreg_b32 s43, hwreg(HW_REG_XCC_ID, 0, 3)
    v_cmp_eq_u32 vcc, 0, v2
    s_nop 1
    v_cndmask_b32 v80, 0, v4, vcc
    v_cmp_eq_u32 vcc, 1, v2
    s_nop 1
    v_cndmask_b32 v81, 0, v4, vcc
    v_cmp_eq_u32 vcc, 2, v2
    s_nop 1
    v_cndmask_b32 v82, 0, v4, vcc
    v_cmp_eq_u32 vcc, 3, v2
    s_nop 1
    v_cndmask_b32 v83, 0, v4, vcc
    v_lshrrev_b32 v2, 5, v1
    v_lshlrev_b32 v5, 8, v2
    v_and_b32 v88, 31, v1
    v_lshlrev_b32 v88, 4, v88
    v_lshl_add_u32 v88, v2, 10, v88
    v_and_b32 v2, 7, v1
    v_lshl_add_u32 v5, v2, 5, v5
    v_and_b32 v2, 16, v1
    v_add_u32 v5, v5, v2
    s_lshl_b32 s8, s6, 9
    v_add_u32 v5, s8, v5
    v_lshlrev_b32 v89, 2, v1
    s_lshl_b32 s8, s6, 8
    v_add_u32 v89, s8, v89
    s_mov_b32 s44, 0x00ff00ff
    s_mov_b32 s45, 0xff00ff00
    s_lshl_b32 s8, s10, 9
    s_add_u32 s8, s8, 65536
    s_add_u32 s36, s30, s8
    s_addc_u32 s37, s31, 0
    s_lshl_b32 s8, s3, 13
    s_lshl_b32 s9, s6, 11
    s_add_u32 s8, s8, s9
    s_add_u32 s8, s8, 65536
    s_add_u32 s38, s30, s8
    s_addc_u32 s39, s31, 0
    s_waitcnt vmcnt(8) lgkmcnt(0)
    s_add_u32 s11, s11, 0x9E3779B9
    v_perm_b32 v2, v12, v12, s52
    v_and_b32 v48, v2, v80
    v_and_b32 v49, v2, v81
    v_and_b32 v50, v2, v82
    v_and_b32 v51, v2, v83
    v_perm_b32 v2, v12, v12, s53
    v_and_b32 v52, v2, v80
    v_and_b32 v53, v2, v81
    v_and_b32 v54, v2, v82
    v_and_b32 v55, v2, v83
    v_perm_b32 v2, v13, v13, s52
    v_and_b32 v56, v2, v80
    v_and_b32 v57, v2, v81
    v_and_b32 v58, v2, v82
    v_and_b32 v59, v2, v83
    v_perm_b32 v2, v13, v13, s53
    v_and_b32 v60, v2, v80
    v_and_b32 v61, v2, v81
    v_and_b32 v62, v2, v82
    v_and_b32 v63, v2, v83
    v_perm_b32 v2, v14, v14, s52
    v_and_b32 v64, v2, v80
    v_and_b32 v65, v2, v81
    v_and_b32 v66, v2, v82
    v_and_b32 v67, v2, v83
    v_perm_b32 v2, v14, v14, s53
    v_and_b32 v68, v2, v80
    v_and_b32 v69, v2, v81
    v_and_b32 v70, v2, v82
    v_and_b32 v71, v2, v83
    v_perm_b32 v2, v15, v15, s52
    v_and_b32 v72, v2, v80
    v_and_b32 v73, v2, v81
    v_and_b32 v74, v2, v82
    v_and_b32 v75, v2, v83
    v_perm_b32 v2, v15, v15, s53
    v_and_b32 v76, v2, v80
    v_and_b32 v77, v2, v81
    v_and_b32 v78, v2, v82
    v_and_b32 v79, v2, v83
    v_mov_b32 v9, s11
    v_mov_b32 v11, s11
    v_lshlrev_b32 v4, 3, v1
    s_waitcnt vmcnt(7)
    v_mfma_f32_16x16x32_bf16 v[84:87], v[48:51], v[16:19], 0
    s_waitcnt vmcnt(6)
    v_mov_b32 v2, 2
    ds_write_b32 v0, v2 offset:64
    v_mfma_f32_16x16x32_bf16 v[84:87], v[52:55], v[20:23], v[84:87]
    s_waitcnt vmcnt(5)
    v_mfma_f32_16x16x32_bf16 v[84:87], v[56:59], v[24:27], v[84:87]
    s_waitcnt vmcnt(4)
    v_mov_b32 v2, 4
    ds_write_b32 v0, v2 offset:64
    v_mfma_f32_16x16x32_bf16 v[84:87], v[60:63], v[28:31], v[84:87]
    s_waitcnt vmcnt(3)
    v_mfma_f32_16x16x32_bf16 v[84:87], v[64:67], v[32:35], v[84:87]
    s_waitcnt vmcnt(2)
    v_mov_b32 v2, 6
    ds_write_b32 v0, v2 offset:64
    v_mfma_f32_16x16x32_bf16 v[84:87], v[68:71], v[36:39], v[84:87]
    s_waitcnt vmcnt(1)
    v_mfma_f32_16x16x32_bf16 v[84:87], v[72:75], v[40:43], v[84:87]
    s_waitcnt vmcnt(0)
    v_mov_b32 v2, 8
    ds_write_b32 v0, v2 offset:64
    v_mfma_f32_16x16x32_bf16 v[84:87], v[76:79], v[44:47], v[84:87]
    s_mov_b64 exec, s[44:45]
    s_nop 6
    ds_write_b128 v5, v[84:87] offset:4096
    s_mov_b64 exec, 1
    ds_add_rtn_u32 v2, v3, v7 offset:0
    s_mov_b32 exec_lo, -1
    ds_read_b64 v[48:49], v4 offset:4096
    ds_read_b64 v[50:51], v4 offset:4352
    ds_read_b64 v[52:53], v4 offset:4608
    ds_read_b64 v[54:55], v4 offset:4864
    ds_read_b64 v[56:57], v4 offset:5120
    ds_read_b64 v[58:59], v4 offset:5376
    ds_read_b64 v[60:61], v4 offset:5632
    ds_read_b64 v[62:63], v4 offset:5888
    s_waitcnt lgkmcnt(8)
    v_readfirstlane_b32 s8, v2
    s_cmp_lg_u32 s8, 3
    s_cbranch_scc1 L_Qp_pre
Lspin_1:
    ds_read_b32 v2, v3 offset:48
    s_sub_u32 s42, s42, 1
    s_cbranch_scc1 L_end
    s_waitcnt lgkmcnt(0)
    v_cmp_gt_u32 vcc, 1, v2
    s_cbranch_vccnz Lspin_1
    v_pk_add_f32 v[48:49], v[48:49], v[50:51]
    v_pk_add_f32 v[52:53], v[52:53], v[54:55]
    v_pk_add_f32 v[56:57], v[56:57], v[58:59]
    v_pk_add_f32 v[60:61], v[60:61], v[62:63]
    v_pk_add_f32 v[48:49], v[48:49], v[52:53]
    v_pk_add_f32 v[56:57], v[56:57], v[60:61]
    v_add_f32 v8, v48, v56
    v_add_f32 v10, v49, v57
    v_and_or_b32 v8, v8, -8, s43
    global_store_dwordx4 v6, v[8:11], s[36:37]
    ds_write_b128 v6, v[8:11] offset:1536
    ds_write_b32 v3, v7 offset:52
L_Qp_pre:
    s_mov_b64 exec, -1
    s_waitcnt lgkmcnt(0)
L_Qp_loop:
    global_load_dwordx4 v[48:51], v88, s[38:39] sc1
    global_load_dwordx4 v[52:55], v88, s[38:39] offset:512 sc1
    s_sub_u32 s42, s42, 1
    s_cbranch_scc1 L_end
    s_waitcnt vmcnt(0)
    v_xor_b32 v72, s11, v49
    v_xor_b32 v73, s11, v51
    v_xor_b32 v74, s11, v53
    v_xor_b32 v75, s11, v55
    v_or3_b32 v72, v72, v73, v74
    v_or_b32 v72, v72, v75
    v_cmp_ne_u32 vcc, 0, v72
    s_cbranch_vccnz L_Qp_loop
    v_xor_b32 v72, s43, v48
    v_xor_b32 v73, s43, v52
    v_and_b32 v48, -8, v48
    v_and_b32 v52, -8, v52
    v_add_f32 v74, v48, v52
    v_add_f32 v75, v50, v54
    v_or_b32 v72, v72, v73
    v_cvt_pk_bf16_f32 v74, v74, v75
    v_and_b32 v72, 7, v72
    ds_write_b32 v89, v74 offset:512
    v_cmp_ne_u32 vcc, 0, v72
    s_cbranch_vccz L_loc
    ds_write_b32 v3, v7 offset:24
L_loc:
    s_mov_b64 exec, 1
    ds_add_u32 v3, v7 offset:4
    s_mov_b64 exec, -1
    s_branch L_W0
L_stub_1:
    s_branch L_touch_ret
L_touch_ret2:
    s_cmp_lg_u32 s6, 0
    s_cbranch_scc1 L_V2
    s_waitcnt vmcnt(0)
    ds_write_b32 v3, v7 offset:48
L_V2:
    s_mov_b32 s52, 0x05040100
    s_mov_b32 s53, 0x07060302
    v_lshlrev_b32 v13, 6, v2
    v_bfe_u32 v2, v1, 2, 2
    v_lshl_add_u32 v13, v2, 4, v13
    s_lshl_b32 s8, s6, 9
    v_add_u32 v13, s8, v13
    v_add_u32 v11, s9, v6
    s_lshl_b32 s8, s6, 11
    v_add_u32 v14, s8, v6
    s_mov_b32 s54, 0
    v_xor_b32 v5, 0, v11
    v_xor_b32 v12, 69632, v11
Lspin_9:
    ds_read_b32 v2, v0 offset:80
    s_sub_u32 s42, s42, 1
    s_cbranch_scc1 L_end
    s_waitcnt lgkmcnt(0)
    v_cmp_gt_u32 vcc, 12, v2
    s_cbranch_vccnz Lspin_9
    global_load_dwordx4 v[16:19], v5, s[14:15] nt
    global_load_dwordx4 v[20:23], v12, s[14:15] nt
    v_xor_b32 v5, 139264, v11
    v_xor_b32 v12, 208896, v11
Lspin_10:
    ds_read_b32 v2, v0 offset:80
    s_sub_u32 s42, s42, 1
    s_cbranch_scc1 L_end
    s_waitcnt lgkmcnt(0)
    v_cmp_gt_u32 vcc, 14, v2
    s_cbranch_vccnz Lspin_10
    global_load_dwordx4 v[24:27], v5, s[14:15] nt
    global_load_dwordx4 v[28:31], v12, s[14:15] nt
    v_xor_b32 v5, 278528, v11
    v_xor_b32 v12, 348160, v11
Lspin_11:
    ds_read_b32 v2, v0 offset:80
    s_sub_u32 s42, s42, 1
    s_cbranch_scc1 L_end
    s_waitcnt lgkmcnt(0)
    v_cmp_gt_u32 vcc, 16, v2
    s_cbranch_vccnz Lspin_11
    global_load_dwordx4 v[32:35], v5, s[14:15] nt
    global_load_dwordx4 v[36:39], v12, s[14:15] nt
    v_xor_b32 v5, 417792, v11
    v_xor_b32 v12, 487424, v11
    ds_read_b32 v2, v3 offset:4
    s_waitcnt lgkmcnt(0)
    v_cmp_gt_u32 vcc, 4, v2
    s_cbranch_vccz Lvs_12
    s_waitcnt vmcnt(4)
Lvs_12:
    global_load_dwordx4 v[40:43], v5, s[14:15] nt
    global_load_dwordx4 v[44:47], v12, s[14:15] nt
    v_xor_b32 v5, 557056, v11
    v_xor_b32 v12, 626688, v11
    ds_read_b32 v2, v3 offset:4
    s_waitcnt lgkmcnt(0)
    v_cmp_gt_u32 vcc, 4, v2
    s_cbranch_vccz Lvs_13
    s_waitcnt vmcnt(4)
Lvs_13:
    global_load_dwordx4 v[48:51], v5, s[14:15] nt
    global_load_dwordx4 v[52:55], v12, s[14:15] nt
    v_xor_b32 v5, 696320, v11
    v_xor_b32 v12, 765952, v11
    ds_read_b32 v2, v3 offset:4
    s_waitcnt lgkmcnt(0)
    v_cmp_gt_u32 vcc, 4, v2
    s_cbranch_vccz Lvs_14
    s_waitcnt vmcnt(4)
Lvs_14:
    global_load_dwordx4 v[56:59], v5, s[14:15] nt
    global_load_dwordx4 v[60:63], v12, s[14:15] nt
    v_xor_b32 v5, 835584, v11
    v_xor_b32 v12, 905216, v11
    ds_read_b32 v2, v3 offset:4
    s_waitcnt lgkmcnt(0)
    v_cmp_gt_u32 vcc, 4, v2
    s_cbranch_vccz Lvs_15
    s_waitcnt vmcnt(4)
Lvs_15:
    s_waitcnt vmcnt(10)
    global_load_dwordx4 v[64:67], v5, s[14:15] nt
    global_load_dwordx4 v[68:71], v12, s[14:15] nt
    v_perm_b32 v80, v20, v16, s52
    v_perm_b32 v84, v20, v16, s53
    v_perm_b32 v88, v21, v17, s52
    v_perm_b32 v92, v21, v17, s53
    v_perm_b32 v96, v22, v18, s52
    v_perm_b32 v100, v22, v18, s53
    v_perm_b32 v104, v23, v19, s52
    v_perm_b32 v108, v23, v19, s53
    v_xor_b32 v5, 974848, v11
    v_xor_b32 v12, 1044480, v11
    ds_read_b32 v2, v3 offset:4
    s_waitcnt lgkmcnt(0)
    v_cmp_gt_u32 vcc, 4, v2
    s_cbranch_vccz Lvs_16
    s_waitcnt vmcnt(4)
Lvs_16:
    s_waitcnt vmcnt(10)
    global_load_dwordx4 v[72:75], v5, s[14:15] nt
    global_load_dwordx4 v[76:79], v12, s[14:15] nt
    s_mov_b64 exec, 1
    ds_add_u32 v3, v7 offset:28
    s_mov_b64 exec, -1
    v_perm_b32 v81, v28, v24, s52
    v_perm_b32 v85, v28, v24, s53
    v_perm_b32 v89, v29, v25, s52
    v_perm_b32 v93, v29, v25, s53
    v_perm_b32 v97, v30, v26, s52
    v_perm_b32 v101, v30, v26, s53
    v_perm_b32 v105, v31, v27, s52
    v_perm_b32 v109, v31, v27, s53
    s_branch L_V2b
L_c2:
    s_sub_u32 s54, s54, 1
    s_cbranch_scc1 L_repub
    ds_read_b32 v2, v3 offset:4
    s_sub_u32 s42, s42, 1
    s_cbranch_scc1 L_end
    s_waitcnt lgkmcnt(0)
    v_cmp_gt_u32 vcc, 4, v2
    s_cbranch_vccnz L_c2
    ds_read_b128 v[80:83], v4 offset:512
    ds_read_b32 v2, v3 offset:24
    s_add_u32 s11, s11, 0x9E3779B9
    s_waitcnt lgkmcnt(0)
    v_mfma_f32_16x16x32_bf16 v[12:15], v[16:19], v[80:83], 0
    v_mfma_f32_16x16x32_bf16 v[16:19], v[20:23], v[80:83], 0
    v_mfma_f32_16x16x32_bf16 v[20:23], v[24:27], v[80:83], 0
    v_mfma_f32_16x16x32_bf16 v[24:27], v[28:31], v[80:83], 0
    v_mfma_f32_16x16x32_bf16 v[28:31], v[32:35], v[80:83], 0
    v_mfma_f32_16x16x32_bf16 v[32:35], v[36:39], v[80:83], 0
    v_mfma_f32_16x16x32_bf16 v[36:39], v[40:43], v[80:83], 0
    v_mfma_f32_16x16x32_bf16 v[40:43], v[44:47], v[80:83], 0
    v_readfirstlane_b32 s43, v2
    v_mfma_f32_16x16x32_bf16 v[44:47], v[48:51], v[80:83], 0
    v_mov_b32_dpp v84, v12 quad_perm:[0,0,0,0] row_mask:0xf bank_mask:0xf
    v_mov_b32_dpp v85, v16 quad_perm:[0,0,0,0] row_mask:0xf bank_mask:0xf
    v_mfma_f32_16x16x32_bf16 v[48:51], v[52:55], v[80:83], 0
    v_mov_b32_dpp v86, v20 quad_perm:[0,0,0,0] row_mask:0xf bank_mask:0xf
    v_mov_b32_dpp v87, v24 quad_perm:[0,0,0,0] row_mask:0xf bank_mask:0xf
    v_mfma_f32_16x16x32_bf16 v[52:55], v[56:59], v[80:83], 0
    v_add_f32_dpp v84, v13, v84 quad_perm:[1,1,1,1] row_mask:0xf bank_mask:0xf
    v_add_f32_dpp v85, v17, v85 quad_perm:[1,1,1,1] row_mask:0xf bank_mask:0xf
    v_mfma_f32_16x16x32_bf16 v[56:59], v[60:63], v[80:83], 0
    v_add_f32_dpp v86, v21, v86 quad_perm:[1,1,1,1] row_mask:0xf bank_mask:0xf
    v_add_f32_dpp v87, v25, v87 quad_perm:[1,1,1,1] row_mask:0xf bank_mask:0xf
    v_mfma_f32_16x16x32_bf16 v[60:63], v[64:67], v[80:83], 0
    v_add_f32_dpp v84, v14, v84 quad_perm:[2,2,2,2] row_mask:0xf bank_mask:0xf
    v_add_f32_dpp v85, v18, v85 quad_perm:[2,2,2,2] row_mask:0xf bank_mask:0xf
    v_mfma_f32_16x16x32_bf16 v[64:67], v[68:71], v[80:83], 0
    v_add_f32_dpp v86, v22, v86 quad_perm:[2,2,2,2] row_mask:0xf bank_mask:0xf
    v_add_f32_dpp v87, v26, v87 quad_perm:[2,2,2,2] row_mask:0xf bank_mask:0xf
    v_mfma_f32_16x16x32_bf16 v[68:71], v[72:75], v[80:83], 0
    v_add_f32_dpp v84, v15, v84 quad_perm:[3,3,3,3] row_mask:0xf bank_mask:0xf
    v_add_f32_dpp v85, v19, v85 quad_perm:[3,3,3,3] row_mask:0xf bank_mask:0xf
    v_mfma_f32_16x16x32_bf16 v[72:75], v[76:79], v[80:83], 0
    v_add_f32_dpp v86, v23, v86 quad_perm:[3,3,3,3] row_mask:0xf bank_mask:0xf
    v_add_f32_dpp v87, v27, v87 quad_perm:[3,3,3,3] row_mask:0xf bank_mask:0xf
    v_mov_b32_dpp v88, v28 quad_perm:[0,0,0,0] row_mask:0xf bank_mask:0xf
    v_mov_b32_dpp v89, v32 quad_perm:[0,0,0,0] row_mask:0xf bank_mask:0xf
    v_mov_b32_dpp v90, v36 quad_perm:[0,0,0,0] row_mask:0xf bank_mask:0xf
    v_mov_b32_dpp v91, v40 quad_perm:[0,0,0,0] row_mask:0xf bank_mask:0xf
    v_add_f32_dpp v88, v29, v88 quad_perm:[1,1,1,1] row_mask:0xf bank_mask:0xf
    v_add_f32_dpp v89, v33, v89 quad_perm:[1,1,1,1] row_mask:0xf bank_mask:0xf
    v_add_f32_dpp v90, v37, v90 quad_perm:[1,1,1,1] row_mask:0xf bank_mask:0xf
    v_add_f32_dpp v91, v41, v91 quad_perm:[1,1,1,1] row_mask:0xf bank_mask:0xf
    v_add_f32_dpp v88, v30, v88 quad_perm:[2,2,2,2] row_mask:0xf bank_mask:0xf
    v_add_f32_dpp v89, v34, v89 quad_perm:[2,2,2,2] row_mask:0xf bank_mask:0xf
    v_add_f32_dpp v90, v38, v90 quad_perm:[2,2,2,2] row_mask:0xf bank_mask:0xf
    v_add_f32_dpp v91, v42, v91 quad_perm:[2,2,2,2] row_mask:0xf bank_mask:0xf
    s_branch L_stubskip_2
L_stub_2:
    s_branch L_touch_ret
L_stubskip_2:
    v_add_f32_dpp v88, v31, v88 quad_perm:[3,3,3,3] row_mask:0xf bank_mask:0xf
    v_add_f32_dpp v89, v35, v89 quad_perm:[3,3,3,3] row_mask:0xf bank_mask:0xf
    v_add_f32_dpp v90, v39, v90 quad_perm:[3,3,3,3] row_mask:0xf bank_mask:0xf
    v_add_f32_dpp v91, v43, v91 quad_perm:[3,3,3,3] row_mask:0xf bank_mask:0xf
    v_mov_b32_dpp v92, v44 quad_perm:[0,0,0,0] row_mask:0xf bank_mask:0xf
    v_mov_b32_dpp v93, v48 quad_perm:[0,0,0,0] row_mask:0xf bank_mask:0xf
    v_mov_b32_dpp v94, v52 quad_perm:[0,0,0,0] row_mask:0xf bank_mask:0xf
    v_mov_b32_dpp v95, v56 quad_perm:[0,0,0,0] row_mask:0xf bank_mask:0xf
    v_add_f32_dpp v92, v45, v92 quad_perm:[1,1,1,1] row_mask:0xf bank_mask:0xf
    v_add_f32_dpp v93, v49, v93 quad_perm:[1,1,1,1] row_mask:0xf bank_mask:0xf
    v_add_f32_dpp v94, v53, v94 quad_perm:[1,1,1,1] row_mask:0xf bank_mask:0xf
    v_add_f32_dpp v95, v57, v95 quad_perm:[1,1,1,1] row_mask:0xf bank_mask:0xf
    v_add_f32_dpp v92, v46, v92 quad_perm:[2,2,2,2] row_mask:0xf bank_mask:0xf
    v_add_f32_dpp v93, v50, v93 quad_perm:[2,2,2,2] row_mask:0xf bank_mask:0xf
    v_add_f32_dpp v94, v54, v94 quad_perm:[2,2,2,2] row_mask:0xf bank_mask:0xf
    v_add_f32_dpp v95, v58, v95 quad_perm:[2,2,2,2] row_mask:0xf bank_mask:0xf
    v_add_f32_dpp v92, v47, v92 quad_perm:[3,3,3,3] row_mask:0xf bank_mask:0xf
    v_add_f32_dpp v93, v51, v93 quad_perm:[3,3,3,3] row_mask:0xf bank_mask:0xf
    v_add_f32_dpp v94, v55, v94 quad_perm:[3,3,3,3] row_mask:0xf bank_mask:0xf
    v_add_f32_dpp v95, v59, v95 quad_perm:[3,3,3,3] row_mask:0xf bank_mask:0xf
    v_mov_b32_dpp v96, v60 quad_perm:[0,0,0,0] row_mask:0xf bank_mask:0xf
    v_mov_b32_dpp v97, v64 quad_perm:[0,0,0,0] row_mask:0xf bank_mask:0xf
    v_mov_b32_dpp v98, v68 quad_perm:[0,0,0,0] row_mask:0xf bank_mask:0xf
    v_mov_b32_dpp v99, v72 quad_perm:[0,0,0,0] row_mask:0xf bank_mask:0xf
    v_add_f32_dpp v96, v61, v96 quad_perm:[1,1,1,1] row_mask:0xf bank_mask:0xf
    v_add_f32_dpp v97, v65, v97 quad_perm:[1,1,1,1] row_mask:0xf bank_mask:0xf
    v_add_f32_dpp v98, v69, v98 quad_perm:[1,1,1,1] row_mask:0xf bank_mask:0xf
    v_add_f32_dpp v99, v73, v99 quad_perm:[1,1,1,1] row_mask:0xf bank_mask:0xf
    v_add_f32_dpp v96, v62, v96 quad_perm:[2,2,2,2] row_mask:0xf bank_mask:0xf
    v_add_f32_dpp v97, v66, v97 quad_perm:[2,2,2,2] row_mask:0xf bank_mask:0xf
    v_add_f32_dpp v98, v70, v98 quad_perm:[2,2,2,2] row_mask:0xf bank_mask:0xf
    v_add_f32_dpp v99, v74, v99 quad_perm:[2,2,2,2] row_mask:0xf bank_mask:0xf
    v_add_f32_dpp v96, v63, v96 quad_perm:[3,3,3,3] row_mask:0xf bank_mask:0xf
    v_add_f32_dpp v97, v67, v97 quad_perm:[3,3,3,3] row_mask:0xf bank_mask:0xf
    v_add_f32_dpp v98, v71, v98 quad_perm:[3,3,3,3] row_mask:0xf bank_mask:0xf
    v_add_f32_dpp v99, v75, v99 quad_perm:[3,3,3,3] row_mask:0xf bank_mask:0xf
    v_cndmask_b32 v84, v84, v88, s[46:47]
    v_cndmask_b32 v85, v85, v89, s[46:47]
    v_cndmask_b32 v86, v86, v90, s[46:47]
    v_cndmask_b32 v87, v87, v91, s[46:47]
    v_cndmask_b32 v84, v84, v92, s[48:49]
    v_cndmask_b32 v85, v85, v93, s[48:49]
    v_cndmask_b32 v86, v86, v94, s[48:49]
    v_cndmask_b32 v87, v87, v95, s[48:49]
    v_cndmask_b32 v84, v84, v96, s[50:51]
    v_cndmask_b32 v85, v85, v97, s[50:51]
    v_cndmask_b32 v86, v86, v98, s[50:51]
    v_cndmask_b32 v87, v87, v99, s[50:51]
    v_cvt_pk_bf16_f32 v88, v84, v85
    v_cvt_pk_bf16_f32 v89, v86, v87
    s_mov_b32 s8, 0x3db504f3
    v_lshlrev_b32 v84, 16, v88
    v_and_b32 v85, 0xffff0000, v88
    v_lshlrev_b32 v86, 16, v89
    v_and_b32 v87, 0xffff0000, v89
    v_mul_f32 v84, s8, v84
    v_mul_f32 v85, s8, v85
    v_mul_f32 v86, s8, v86
    v_mul_f32 v87, s8, v87
    v_cvt_pk_bf16_f32 v88, v84, v85
    v_cvt_pk_bf16_f32 v89, v86, v87
    v_lshlrev_b32 v84, 16, v88
    v_and_b32 v85, 0xffff0000, v88
    v_lshlrev_b32 v86, 16, v89
    v_and_b32 v87, 0xffff0000, v89
    v_max3_f32 v88, v84, v85, v86
    v_max_f32 v88, v88, v87
    s_nop 1
    v_max_f32_dpp v88, v88, v88 quad_perm:[1,0,3,2] row_mask:0xf bank_mask:0xf
    s_nop 1
    v_max_f32_dpp v88, v88, v88 quad_perm:[2,3,0,1] row_mask:0xf bank_mask:0xf
    s_mov_b64 exec, s[44:45]
    ds_max_f32 v11, v88 offset:128
    s_mov_b64 exec, 1
    ds_add_u32 v3, v7 offset:8
    s_mov_b64 exec, -1
    s_mov_b32 s8, 0x3fb8aa3b
L_c3:
    ds_read_b32 v2, v3 offset:8
    ds_read_b32 v88, v11 offset:128
    s_sub_u32 s42, s42, 1
    s_cbranch_scc1 L_end
    s_waitcnt lgkmcnt(0)
    v_cmp_gt_u32 vcc, 4, v2
    s_cbranch_vccnz L_c3
    v_sub_f32 v84, v84, v88
    v_sub_f32 v85, v85, v88
    v_sub_f32 v86, v86, v88
    v_sub_f32 v87, v87, v88
    v_mul_f32 v84, s8, v84
    v_mul_f32 v85, s8, v85
    v_mul_f32 v86, s8, v86
    v_mul_f32 v87, s8, v87
    v_exp_f32 v84, v84
    v_exp_f32 v85, v85
    v_exp_f32 v86, v86
    v_exp_f32 v87, v87
    v_cvt_pk_bf16_f32 v90, v84, v85
    v_add_f32 v84, v84, v85
    v_cvt_pk_bf16_f32 v91, v86, v87
    ds_write_b64 v5, v[90:91] offset:2048
    ds_write_b32 v0, v7 offset:32
    v_add_f32 v86, v86, v87
    v_add_f32 v84, v84, v86
    s_nop 1
    v_add_f32_dpp v84, v84, v84 quad_perm:[1,0,3,2] row_mask:0xf bank_mask:0xf
    s_nop 1
    v_add_f32_dpp v84, v84, v84 quad_perm:[2,3,0,1] row_mask:0xf bank_mask:0xf
    s_mov_b64 exec, s[44:45]
    ds_write_b32 v100, v84 offset:256
    s_mov_b64 exec, 1
    ds_add_rtn_u32 v2, v3, v7 offset:12
    s_mov_b64 exec, 15
    v_lshlrev_b32 v36, 6, v1
    v_lshlrev_b32 v4, 2, v1
    ds_read_b128 v[16:19], v36 offset:256
    ds_read_b128 v[20:23], v36 offset:272
    ds_read_b128 v[24:27], v36 offset:288
    s_branch L_stubskip_3
L_stub_3:
    s_branch L_touch_ret
L_stubskip_3:
    ds_read_b128 v[28:31], v36 offset:304
    ds_read_b32 v32, v4 offset:128
    v_mov_b32 v33, s11
    v_mov_b32 v35, s11
    s_waitcnt lgkmcnt(0)
    v_readfirstlane_b32 s8, v2
    s_cmp_lg_u32 s8, 3
    s_cbranch_scc1 L_Kpost
    v_pk_add_f32 v[16:17], v[16:17], v[18:19]
    v_pk_add_f32 v[20:21], v[20:21], v[22:23]
    v_pk_add_f32 v[24:25], v[24:25], v[26:27]
    v_pk_add_f32 v[28:29], v[28:29], v[30:31]
    v_pk_add_f32 v[16:17], v[16:17], v[20:21]
    v_pk_add_f32 v[24:25], v[24:25], v[28:29]
    v_pk_add_f32 v[16:17], v[16:17], v[24:25]
    v_add_f32 v34, v16, v17
    s_cmp_lg_u32 s43, 0
    s_cbranch_scc1 L_Knl
    global_store_dwordx4 v6, v[32:35], s[36:37]
L_Kpost:
    s_setprio 1
    s_mov_b64 exec, -1
    s_cmp_eq_u32 s6, 0
    s_cbranch_scc1 L_F1
    s_cmp_eq_u32 s6, 3
    s_cbranch_scc1 L_probe
    s_cmp_lg_u32 s6, 1
    s_cbranch_scc1 L_Kend
    s_lshl_b32 s8, s3, 11
    s_lshr_b32 s9, s4, 2
    s_lshl_b32 s9, s9, 4
    s_add_u32 s8, s8, s9
    s_add_u32 s8, s8, 1048576
    s_add_u32 s38, s30, s8
    s_addc_u32 s39, s31, 0
    v_lshlrev_b32 v4, 7, v1
    v_lshlrev_b32 v5, 2, v1
    s_mov_b64 exec, 0xffff
    s_mov_b32 s8, 0x3fb8aa3b
L_Mp_loop:
    global_load_dwordx4 v[20:23], v4, s[38:39] sc1
    s_sub_u32 s42, s42, 1
    s_cbranch_scc1 L_end
    s_waitcnt vmcnt(0)
    v_xor_b32 v2, s11, v21
    v_xor_b32 v16, s11, v23
    v_or_b32 v2, v2, v16
    v_cmp_ne_u32 vcc, 0, v2
    s_cbranch_vccnz L_Mp_loop
    v_max_f32_dpp v18, v20, v20 row_ror:8 row_mask:0xf bank_mask:0xf
    s_nop 1
    v_max_f32_dpp v18, v18, v18 row_ror:4 row_mask:0xf bank_mask:0xf
    s_nop 1
    v_max_f32_dpp v18, v18, v18 row_ror:2 row_mask:0xf bank_mask:0xf
    s_nop 1
    v_max_f32_dpp v18, v18, v18 row_ror:1 row_mask:0xf bank_mask:0xf
    v_sub_f32 v16, v20, v18
    v_mul_f32 v16, s8, v16
    v_exp_f32 v16, v16
    s_nop 0
    v_mul_f32 v17, v16, v22
    s_nop 1
    v_add_f32_dpp v17, v17, v17 row_ror:8 row_mask:0xf bank_mask:0xf
    s_nop 1
    v_add_f32_dpp v17, v17, v17 row_ror:4 row_mask:0xf bank_mask:0xf
    s_nop 1
    v_add_f32_dpp v17, v17, v17 row_ror:2 row_mask:0xf bank_mask:0xf
    s_nop 1
    v_add_f32_dpp v17, v17, v17 row_ror:1 row_mask:0xf bank_mask:0xf
    v_rcp_f32 v17, v17
    s_nop 0
    v_mul_f32 v16, v16, v17
    v_and_b32 v16, 0x7fffffff, v16
    ds_write_b32 v5, v16 offset:192
    s_endpgm
L_W0:
    s_lshl_b32 s8, s5, 19
    s_lshr_b32 s9, s4, 2
    s_lshl_b32 s22, s9, 17
    s_add_u32 s8, s8, s22
    s_lshl_b32 s22, s6, 15
    s_add_u32 s8, s8, s22
    s_and_b32 s23, s4, 3
    s_lshl_b32 s22, s23, 8
    s_add_u32 s8, s8, s22
    s_add_u32 s8, s8, 4096
    s_add_u32 s34, s18, s8
    s_addc_u32 s35, s19, 0
    v_lshrrev_b32 v2, 4, v1
    v_and_b32 v5, 15, v1
    v_lshlrev_b32 v4, 13, v2
    v_lshl_add_u32 v4, v5, 4, v4
    v_lshlrev_b32 v8, 5, v5
    v_lshl_add_u32 v8, v2, 3, v8
    v_lshlrev_b32 v5, 8, v5
    v_lshl_add_u32 v5, v2, 4, v5
    v_lshlrev_b32 v9, 4, v2
    v_mov_b32 v10, 0xff800000
    v_and_b32 v13, 0x1f0, v6
    v_lshrrev_b32 v14, 5, v1
    v_lshl_add_u32 v14, v14, 13, v13
    s_lshl_b32 s8, s6, 9
    v_add_u32 v8, s8, v8
    s_lshl_b32 s8, s3, 14
    s_lshl_b32 s9, s9, 12
    s_add_u32 s8, s8, s9
    s_lshl_b32 s9, s6, 6
    s_add_u32 s8, s8, s9
    s_add_u32 s8, s8, 524288
    s_add_u32 s38, s30, s8
    s_addc_u32 s39, s31, 0
    s_lshl_b32 s8, s23, 16
    s_lshl_b32 s23, s10, 7
    s_and_b32 s23, s23, 0x1e00
    s_add_u32 s8, s8, s23
    s_lshr_b32 s23, s10, 6
    s_lshl_b32 s23, s23, 14
    s_add_u32 s8, s8, s23
    s_add_u32 s8, s8, 1310720
    s_add_u32 s36, s30, s8
    s_addc_u32 s37, s31, 0
    s_mov_b32 s52, 0x05040100
    s_mov_b32 s53, 0x07060302
    s_mov_b32 s44, 0x07060500
    s_mov_b32 s45, 0x07060501
    s_mov_b32 s46, 0x07060502
    s_mov_b32 s47, 0x07060503
Lspin_2:
    s_sleep 1
    ds_read_b32 v2, v3 offset:4
    s_sub_u32 s42, s42, 1
    s_cbranch_scc1 L_end
    s_waitcnt lgkmcnt(0)
    v_cmp_gt_u32 vcc, 4, v2
    s_cbranch_vccnz Lspin_2
Lspin_3:
    s_sleep 1
    ds_read_b32 v2, v3 offset:28
    s_sub_u32 s42, s42, 1
    s_cbranch_scc1 L_end
    s_waitcnt lgkmcnt(0)
    v_cmp_gt_u32 vcc, 4, v2
    s_cbranch_vccnz Lspin_3
    global_load_dwordx4 v[16:19], v4, s[34:35] offset:-4096 nt
    global_load_dwordx4 v[20:23], v4, s[34:35] offset:-3072 nt
    global_load_dwordx4 v[24:27], v4, s[34:35] offset:-2048 nt
    global_load_dwordx4 v[28:31], v4, s[34:35] offset:-1024 nt
    global_load_dwordx4 v[32:35], v4, s[34:35] offset:0 nt
    global_load_dwordx4 v[36:39], v4, s[34:35] offset:1024 nt
    global_load_dwordx4 v[40:43], v4, s[34:35] offset:2048 nt
    global_load_dwordx4 v[44:47], v4, s[34:35] offset:3072 nt
    ds_read_b32 v2, v3 offset:24
    s_waitcnt lgkmcnt(0)
    v_cmp_ne_u32 vcc, 0, v2
    s_cbranch_vccnz L_Wnl
L_Wloc:
    s_waitcnt vmcnt(6)
    v_perm_b32 v48, v20, v16, s52
    v_perm_b32 v52, v20, v16, s53
    v_perm_b32 v56, v21, v17, s52
    v_perm_b32 v60, v21, v17, s53
    v_perm_b32 v64, v22, v18, s52
    v_perm_b32 v68, v22, v18, s53
    v_perm_b32 v72, v23, v19, s52
    v_perm_b32 v76, v23, v19, s53
    s_waitcnt vmcnt(4)
    v_perm_b32 v49, v28, v24, s52
    v_perm_b32 v53, v28, v24, s53
    v_perm_b32 v57, v29, v25, s52
    v_perm_b32 v61, v29, v25, s53
    v_perm_b32 v65, v30, v26, s52
    v_perm_b32 v69, v30, v26, s53
    v_perm_b32 v73, v31, v27, s52
    v_perm_b32 v77, v31, v27, s53
    s_waitcnt vmcnt(2)
    v_perm_b32 v50, v36, v32, s52
    v_perm_b32 v54, v36, v32, s53
    v_perm_b32 v58, v37, v33, s52
    v_perm_b32 v62, v37, v33, s53
    v_perm_b32 v66, v38, v34, s52
    v_perm_b32 v70, v38, v34, s53
    v_perm_b32 v74, v39, v35, s52
    v_perm_b32 v78, v39, v35, s53
    s_setprio 0
Lspin_4:
    ds_read_b32 v2, v3 offset:56
    s_sub_u32 s42, s42, 1
    s_cbranch_scc1 L_end
    s_waitcnt lgkmcnt(0)
    v_cmp_gt_u32 vcc, 1, v2
    s_cbranch_vccnz Lspin_4
    s_setprio 3
    global_load_dwordx4 v[80:83], v5, s[38:39] sc1
    s_waitcnt vmcnt(1)
    v_perm_b32 v51, v44, v40, s52
    v_perm_b32 v55, v44, v40, s53
    v_perm_b32 v59, v45, v41, s52
    v_perm_b32 v63, v45, v41, s53
    v_perm_b32 v67, v46, v42, s52
    v_perm_b32 v71, v46, v42, s53
    v_perm_b32 v75, v47, v43, s52
    v_perm_b32 v79, v47, v43, s53
L_Op_wait:
    s_waitcnt vmcnt(0)
    v_max3_u32 v2, v80, v81, v82
    v_max_u32 v2, v2, v83
    s_branch L_stubskip_4
L_stub_4:
    s_branch L_touch_ret2
L_stubskip_4:
    v_cmp_eq_u32 vcc, -1, v2
    s_cbranch_vccnz L_Op_loop
    s_mov_b64 exec, -1
L_Op_done:
    ds_read_b128 v[84:87], v9 offset:192
    v_mfma_f32_16x16x32_bf16 v[16:19], v[80:83], v[48:51], 0
    v_mfma_f32_16x16x32_bf16 v[20:23], v[80:83], v[52:55], 0
    v_mfma_f32_16x16x32_bf16 v[24:27], v[80:83], v[56:59], 0
    v_mfma_f32_16x16x32_bf16 v[28:31], v[80:83], v[60:63], 0
    s_nop 0
L_f_wait:
    s_waitcnt lgkmcnt(0)
    v_cmp_eq_u32 vcc, v10, v84
    s_cbranch_vccnz L_f_loop
    v_mfma_f32_16x16x32_bf16 v[32:35], v[80:83], v[64:67], 0
    v_mul_f32 v88, v84, v16
    v_fmac_f32 v88, v85, v17
    v_mfma_f32_16x16x32_bf16 v[36:39], v[80:83], v[68:71], 0
    v_mul_f32 v89, v84, v20
    v_fmac_f32 v89, v85, v21
    v_mfma_f32_16x16x32_bf16 v[40:43], v[80:83], v[72:75], 0
    v_mul_f32 v90, v84, v24
    v_fmac_f32 v90, v85, v25
    v_mfma_f32_16x16x32_bf16 v[44:47], v[80:83], v[76:79], 0
    v_mul_f32 v91, v84, v28
    v_fmac_f32 v91, v85, v29
    v_fmac_f32 v88, v86, v18
    v_fmac_f32 v88, v87, v19
    v_fmac_f32 v89, v86, v22
    v_fmac_f32 v89, v87, v23
    v_fmac_f32 v90, v86, v26
    v_fmac_f32 v90, v87, v27
    v_fmac_f32 v91, v86, v30
    v_fmac_f32 v91, v87, v31
    v_mul_f32 v92, v84, v32
    v_fmac_f32 v92, v85, v33
    v_permlane16_swap_b32 v88, v90
    v_permlane16_swap_b32 v89, v91
    v_mul_f32 v93, v84, v36
    v_fmac_f32 v93, v85, v37
    v_mul_f32 v94, v84, v40
    v_fmac_f32 v94, v85, v41
    v_mul_f32 v95, v84, v44
    v_fmac_f32 v95, v85, v45
    v_add_f32 v88, v88, v90
    v_add_f32 v89, v89, v91
    v_fmac_f32 v92, v86, v34
    v_fmac_f32 v92, v87, v35
    v_fmac_f32 v94, v86, v42
    v_fmac_f32 v94, v87, v43
    v_fmac_f32 v93, v86, v38
    v_fmac_f32 v93, v87, v39
    v_fmac_f32 v95, v86, v46
    v_fmac_f32 v95, v87, v47
    v_permlane16_swap_b32 v92, v94
    s_nop 0
    v_permlane16_swap_b32 v93, v95
    v_add_f32 v92, v92, v94
    v_add_f32 v93, v93, v95
    s_nop 0
    v_permlane32_swap_b32 v88, v92
    v_permlane32_swap_b32 v89, v93
    v_add_f32 v88, v88, v92
    v_add_f32 v89, v89, v93
    ds_write_b64 v8, v[88:89] offset:6144
    s_mov_b64 exec, 1
    ds_add_rtn_u32 v2, v3, v7 offset:20
    s_mov_b64 exec, -1
    ds_read_b128 v[16:19], v13 offset:6144
    ds_read_b128 v[20:23], v13 offset:6656
    ds_read_b128 v[24:27], v13 offset:7168
    ds_read_b128 v[28:31], v13 offset:7680
    s_waitcnt lgkmcnt(4)
    v_readfirstlane_b32 s8, v2
    s_cmp_lg_u32 s8, 3
    s_cbranch_scc1 L_end
    s_waitcnt lgkmcnt(2)
    v_pk_add_f32 v[16:17], v[16:17], v[20:21]
    v_pk_add_f32 v[18:19], v[18:19], v[22:23]
    s_waitcnt lgkmcnt(0)
    v_pk_add_f32 v[24:25], v[24:25], v[28:29]
    v_pk_add_f32 v[26:27], v[26:27], v[30:31]
    v_pk_add_f32 v[16:17], v[16:17], v[24:25]
    v_pk_add_f32 v[18:19], v[18:19], v[26:27]
    v_perm_b32 v16, v16, v11, s44
    v_perm_b32 v17, v17, v11, s45
    v_perm_b32 v18, v18, v11, s46
    v_perm_b32 v19, v19, v11, s47
    global_store_dwordx4 v14, v[16:19], s[36:37] sc1
    s_endpgm
L_Op_loop:
    s_mov_b64 exec, vcc
    global_load_dwordx4 v[80:83], v5, s[38:39] sc1
    s_sub_u32 s42, s42, 1
    s_cbranch_scc0 L_Op_wait
    s_endpgm
L_f_loop:
    ds_read_b128 v[84:87], v9 offset:192
    s_sub_u32 s42, s42, 1
    s_cbranch_scc0 L_f_wait
    s_endpgm
L_V2b:
    s_setprio 3
    s_waitcnt vmcnt(10)
    v_perm_b32 v82, v36, v32, s52
    v_perm_b32 v86, v36, v32, s53
    v_perm_b32 v90, v37, v33, s52
    v_perm_b32 v94, v37, v33, s53
    v_perm_b32 v98, v38, v34, s52
    v_perm_b32 v102, v38, v34, s53
    v_perm_b32 v106, v39, v35, s52
    v_perm_b32 v110, v39, v35, s53
    s_waitcnt vmcnt(8)
    v_perm_b32 v83, v44, v40, s52
    v_perm_b32 v87, v44, v40, s53
    v_perm_b32 v91, v45, v41, s52
    v_perm_b32 v95, v45, v41, s53
    v_perm_b32 v99, v46, v42, s52
    v_perm_b32 v103, v46, v42, s53
    v_perm_b32 v107, v47, v43, s52
    v_perm_b32 v111, v47, v43, s53
    s_cmp_lg_u32 s54, 0
    s_cbranch_scc1 Lvp_17
    ds_read_b32 v2, v0 offset:32
    s_waitcnt lgkmcnt(0)
    v_cmp_eq_u32 vcc, 0, v2
    s_cbranch_vccnz Lvp_17
    s_call_b64 s[56:57], L_AB
Lvp_17:
    s_waitcnt vmcnt(6)
    v_perm_b32 v16, v52, v48, s52
    v_perm_b32 v20, v52, v48, s53
    v_perm_b32 v24, v53, v49, s52
    v_perm_b32 v28, v53, v49, s53
    v_perm_b32 v32, v54, v50, s52
    v_perm_b32 v36, v54, v50, s53
    v_perm_b32 v40, v55, v51, s52
    v_perm_b32 v44, v55, v51, s53
    s_cmp_lg_u32 s54, 0
    s_cbranch_scc1 Lvp_18
    ds_read_b32 v2, v0 offset:32
    s_waitcnt lgkmcnt(0)
    v_cmp_eq_u32 vcc, 0, v2
    s_cbranch_vccnz Lvp_18
    s_call_b64 s[56:57], L_AB
Lvp_18:
    s_waitcnt vmcnt(4)
    v_perm_b32 v17, v60, v56, s52
    v_perm_b32 v21, v60, v56, s53
    v_perm_b32 v25, v61, v57, s52
    v_perm_b32 v29, v61, v57, s53
    v_perm_b32 v33, v62, v58, s52
    v_perm_b32 v37, v62, v58, s53
    v_perm_b32 v41, v63, v59, s52
    v_perm_b32 v45, v63, v59, s53
    s_cmp_lg_u32 s54, 0
    s_cbranch_scc1 Lvp_19
    ds_read_b32 v2, v0 offset:32
    s_waitcnt lgkmcnt(0)
    v_cmp_eq_u32 vcc, 0, v2
    s_cbranch_vccnz Lvp_19
    s_call_b64 s[56:57], L_AB
Lvp_19:
    s_waitcnt vmcnt(2)
    v_perm_b32 v18, v68, v64, s52
    v_perm_b32 v22, v68, v64, s53
    v_perm_b32 v26, v69, v65, s52
    v_perm_b32 v30, v69, v65, s53
    v_perm_b32 v34, v70, v66, s52
    v_perm_b32 v38, v70, v66, s53
    v_perm_b32 v42, v71, v67, s52
    v_perm_b32 v46, v71, v67, s53
    s_cmp_lg_u32 s54, 0
    s_cbranch_scc1 Lvp_20
    ds_read_b32 v2, v0 offset:32
    s_waitcnt lgkmcnt(0)
    v_cmp_eq_u32 vcc, 0, v2
    s_cbranch_vccnz Lvp_20
    s_call_b64 s[56:57], L_AB
Lvp_20:
    s_waitcnt vmcnt(0)
    v_perm_b32 v19, v76, v72, s52
    v_perm_b32 v23, v76, v72, s53
    v_perm_b32 v27, v77, v73, s52
    v_perm_b32 v31, v77, v73, s53
    v_perm_b32 v35, v78, v74, s52
    v_perm_b32 v39, v78, v74, s53
    v_perm_b32 v43, v79, v75, s52
    v_perm_b32 v47, v79, v75, s53
    s_cmp_lg_u32 s54, 0
    s_cbranch_scc1 L_V3
Lspin_21:
    ds_read_b32 v2, v0 offset:32
    s_sub_u32 s42, s42, 1
    s_cbranch_scc1 L_end
    s_waitcnt lgkmcnt(0)
    v_cmp_gt_u32 vcc, 1, v2
    s_cbranch_vccnz Lspin_21
    s_call_b64 s[56:57], L_AB
    s_branch L_stubskip_5
L_stub_5:
    s_branch L_touch_ret2
L_stubskip_5:
L_V3:
    v_mfma_f32_16x16x32_bf16 v[144:147], v[128:131], v[16:19], v[144:147]
    v_mfma_f32_16x16x32_bf16 v[144:147], v[132:135], v[20:23], v[144:147]
    v_mfma_f32_16x16x32_bf16 v[144:147], v[136:139], v[24:27], v[144:147]
    v_mfma_f32_16x16x32_bf16 v[144:147], v[140:143], v[28:31], v[144:147]
    v_mfma_f32_16x16x32_bf16 v[148:151], v[128:131], v[32:35], v[148:151]
    v_mfma_f32_16x16x32_bf16 v[148:151], v[132:135], v[36:39], v[148:151]
    v_mfma_f32_16x16x32_bf16 v[148:151], v[136:139], v[40:43], v[148:151]
    v_mfma_f32_16x16x32_bf16 v[148:151], v[140:143], v[44:47], v[148:151]
    s_nop 3
    ds_write_b128 v14, v[144:147] offset:8192
    s_nop 2
    ds_write_b128 v14, v[148:151] offset:9216
    s_mov_b64 exec, 1
    ds_add_rtn_u32 v2, v3, v7 offset:16
    s_mov_b64 exec, -1
    ds_read_b128 v[16:19], v6 offset:8192
    ds_read_b128 v[20:23], v6 offset:9216
    ds_read_b128 v[24:27], v6 offset:10240
    ds_read_b128 v[28:31], v6 offset:11264
    ds_read_b128 v[32:35], v6 offset:12288
    ds_read_b128 v[36:39], v6 offset:13312
    ds_read_b128 v[40:43], v6 offset:14336
    ds_read_b128 v[44:47], v6 offset:15360
    s_waitcnt lgkmcnt(8)
    v_readfirstlane_b32 s8, v2
    s_cmp_lg_u32 s8, 3
    s_cbranch_scc1 L_end
    s_waitcnt lgkmcnt(4)
    v_pk_add_f32 v[16:17], v[16:17], v[24:25]
    v_pk_add_f32 v[18:19], v[18:19], v[26:27]
    v_pk_add_f32 v[20:21], v[20:21], v[28:29]
    v_pk_add_f32 v[22:23], v[22:23], v[30:31]
    s_waitcnt lgkmcnt(0)
    v_pk_add_f32 v[32:33], v[32:33], v[40:41]
    v_pk_add_f32 v[34:35], v[34:35], v[42:43]
    v_pk_add_f32 v[36:37], v[36:37], v[44:45]
    v_pk_add_f32 v[38:39], v[38:39], v[46:47]
    v_pk_add_f32 v[16:17], v[16:17], v[32:33]
    v_pk_add_f32 v[18:19], v[18:19], v[34:35]
    v_pk_add_f32 v[20:21], v[20:21], v[36:37]
    v_pk_add_f32 v[22:23], v[22:23], v[38:39]
    v_cvt_pk_bf16_f32 v8, v16, v17
    v_cvt_pk_bf16_f32 v9, v18, v19
    v_cvt_pk_bf16_f32 v10, v20, v21
    v_cvt_pk_bf16_f32 v11, v22, v23
    s_cmp_lg_u32 s43, 0
    v_min_u32 v8, -2, v8
    v_min_u32 v9, -2, v9
    v_min_u32 v10, -2, v10
    v_min_u32 v11, -2, v11
    s_cbranch_scc1 L_Vnl
    global_store_dwordx4 v4, v[8:11], s[36:37]
    ds_write_b32 v3, v7 offset:56
    s_endpgm
L_AB:
    ds_read_b128 v[8:11], v13 offset:2048
    ds_read_b128 v[140:143], v13 offset:2304
    ds_read_b32 v2, v3 offset:24
    s_mov_b32 s54, 1
    s_waitcnt lgkmcnt(0)
    v_cndmask_b32 v112, 0, v8, s[44:45]
    v_cndmask_b32 v113, 0, v9, s[44:45]
    v_cndmask_b32 v114, 0, v10, s[44:45]
    v_cndmask_b32 v115, 0, v11, s[44:45]
    v_cndmask_b32 v116, 0, v8, s[46:47]
    v_cndmask_b32 v117, 0, v9, s[46:47]
    v_cndmask_b32 v118, 0, v10, s[46:47]
    v_cndmask_b32 v119, 0, v11, s[46:47]
    v_mfma_f32_16x16x32_bf16 v[144:147], v[112:115], v[80:83], 0
    v_mfma_f32_16x16x32_bf16 v[148:151], v[112:115], v[96:99], 0
    v_cndmask_b32 v120, 0, v8, s[48:49]
    v_cndmask_b32 v121, 0, v9, s[48:49]
    v_cndmask_b32 v122, 0, v10, s[48:49]
    v_cndmask_b32 v123, 0, v11, s[48:49]
    v_mfma_f32_16x16x32_bf16 v[144:147], v[116:119], v[84:87], v[144:147]
    v_mfma_f32_16x16x32_bf16 v[148:151], v[116:119], v[100:103], v[148:151]
    v_cndmask_b32 v124, 0, v8, s[50:51]
    v_cndmask_b32 v125, 0, v9, s[50:51]
    v_cndmask_b32 v126, 0, v10, s[50:51]
    v_cndmask_b32 v127, 0, v11, s[50:51]
    v_mfma_f32_16x16x32_bf16 v[144:147], v[120:123], v[88:91], v[144:147]
    v_mfma_f32_16x16x32_bf16 v[148:151], v[120:123], v[104:107], v[148:151]
    v_cndmask_b32 v128, 0, v140, s[44:45]
    v_cndmask_b32 v129, 0, v141, s[44:45]
    v_cndmask_b32 v130, 0, v142, s[44:45]
    v_cndmask_b32 v131, 0, v143, s[44:45]
    v_mfma_f32_16x16x32_bf16 v[144:147], v[124:127], v[92:95], v[144:147]
    v_mfma_f32_16x16x32_bf16 v[148:151], v[124:127], v[108:111], v[148:151]
    v_cndmask_b32 v132, 0, v140, s[46:47]
    v_cndmask_b32 v133, 0, v141, s[46:47]
    v_cndmask_b32 v134, 0, v142, s[46:47]
    v_cndmask_b32 v135, 0, v143, s[46:47]
    v_cndmask_b32 v136, 0, v140, s[48:49]
    v_cndmask_b32 v137, 0, v141, s[48:49]
    v_cndmask_b32 v138, 0, v142, s[48:49]
    v_cndmask_b32 v139, 0, v143, s[48:49]
    v_cndmask_b32 v140, 0, v140, s[50:51]
    v_cndmask_b32 v141, 0, v141, s[50:51]
    v_cndmask_b32 v142, 0, v142, s[50:51]
    v_cndmask_b32 v143, 0, v143, s[50:51]
    v_readfirstlane_b32 s43, v2
    s_setpc_b64 s[56:57]
L_F1:
    s_cmp_ge_u32 s2, 128
    s_cbranch_scc1 L_end
    s_lshr_b32 s8, s3, 2
    s_lshl_b32 s9, s8, 16
    s_and_b32 s8, s3, 3
    s_lshl_b32 s8, s8, 7
    s_add_u32 s9, s9, s8
    s_lshl_b32 s8, s4, 4
    s_add_u32 s9, s9, s8
    s_add_u32 s9, s9, 1310720
    s_lshl_b32 s22, s3, 6
    s_lshl_b32 s8, s4, 3
    s_add_u32 s22, s22, s8
    s_add_u32 s36, s30, s9
    s_addc_u32 s37, s31, 0
    v_and_b32 v5, 15, v1
    v_lshlrev_b32 v5, 9, v5
    v_lshrrev_b32 v2, 4, v1
    v_lshl_add_u32 v5, v2, 14, v5
    s_mov_b32 s44, 0x0c0c0400
    s_mov_b32 s45, 0x04000c0c
    s_movk_i32 s48, 0xff00
    global_load_dwordx4 v[16:19], v6, s[20:21]
    global_load_dwordx4 v[20:23], v6, s[24:25]
    s_waitcnt vmcnt(0)
    v_lshlrev_b32 v24, 16, v16
    v_and_b32 v25, 0xffff0000, v16
    v_lshlrev_b32 v26, 16, v20
    v_and_b32 v27, 0xffff0000, v20
    v_mul_f32 v24, v24, v26
    v_mul_f32 v25, v25, v27
    v_cvt_pk_bf16_f32 v24, v24, v25
    v_lshlrev_b32 v28, 16, v24
    v_and_b32 v29, 0xffff0000, v24
    v_lshlrev_b32 v24, 16, v17
    v_and_b32 v25, 0xffff0000, v17
    v_lshlrev_b32 v26, 16, v21
    v_and_b32 v27, 0xffff0000, v21
    v_mul_f32 v24, v24, v26
    v_mul_f32 v25, v25, v27
    v_cvt_pk_bf16_f32 v24, v24, v25
    v_lshlrev_b32 v30, 16, v24
    v_and_b32 v31, 0xffff0000, v24
    v_lshlrev_b32 v24, 16, v18
    v_and_b32 v25, 0xffff0000, v18
    v_lshlrev_b32 v26, 16, v22
    v_and_b32 v27, 0xffff0000, v22
    v_mul_f32 v24, v24, v26
    v_mul_f32 v25, v25, v27
    v_cvt_pk_bf16_f32 v24, v24, v25
    v_lshlrev_b32 v32, 16, v24
    v_and_b32 v33, 0xffff0000, v24
    v_lshlrev_b32 v24, 16, v19
    v_and_b32 v25, 0xffff0000, v19
    v_lshlrev_b32 v26, 16, v23
    v_and_b32 v27, 0xffff0000, v23
    v_mul_f32 v24, v24, v26
    v_mul_f32 v25, v25, v27
    v_cvt_pk_bf16_f32 v24, v24, v25
    v_lshlrev_b32 v34, 16, v24
    v_and_b32 v35, 0xffff0000, v24
    v_pk_add_f32 v[28:29], v[28:29], v[30:31]
    v_pk_add_f32 v[32:33], v[32:33], v[34:35]
    s_branch L_stubskip_6
L_stub_6:
    s_branch L_touch_ret2
L_stubskip_6:
    v_pk_add_f32 v[28:29], v[28:29], v[32:33]
    v_add_f32 v28, v28, v29
    s_nop 1
    v_add_f32_dpp v28, v28, v28 row_ror:8 row_mask:0xf bank_mask:0xf
    s_nop 1
    v_add_f32_dpp v28, v28, v28 row_ror:4 row_mask:0xf bank_mask:0xf
    s_nop 1
    v_add_f32_dpp v28, v28, v28 row_ror:2 row_mask:0xf bank_mask:0xf
    s_nop 1
    v_add_f32_dpp v28, v28, v28 row_ror:1 row_mask:0xf bank_mask:0xf
    v_mov_b32 v29, v28
    s_nop 1
    v_permlane16_swap_b32 v28, v29
    v_add_f32 v28, v28, v29
    v_mov_b32 v29, v28
    s_nop 1
    v_permlane32_swap_b32 v28, v29
    v_add_f32 v28, v28, v29
    v_cvt_pk_bf16_f32 v28, v28, v28
    v_lshlrev_b32 v28, 16, v28
    v_mul_f32 v28, 0xbfb8aa3b, v28
    v_exp_f32 v28, v28
    s_nop 0
    v_add_f32 v28, 1.0, v28
    v_rcp_f32 v28, v28
    s_nop 0
    v_cvt_pk_bf16_f32 v28, v28, v28
    v_lshlrev_b32 v28, 16, v28
    v_sub_f32 v29, 1.0, v28
    v_cvt_pk_bf16_f32 v29, v29, v29
    v_lshlrev_b32 v29, 16, v29
    v_cmp_gt_u32 vcc, 32, v1
    v_lshrrev_b32 v2, 4, v1
    s_nop 0
    v_cndmask_b32 v28, v29, v28, vcc
    v_lshlrev_b32 v2, 1, v2
    v_add_u32 v30, s22, v2
    s_getreg_b32 s8, hwreg(HW_REG_XCC_ID, 0, 3)
    s_lshl_b32 s8, s8, 8
    s_add_u32 s8, s8, 1114112
    s_add_u32 s38, s30, s8
    s_addc_u32 s39, s31, 0
    v_lshlrev_b32 v4, 3, v1
    v_mov_b32 v31, 0xff800000
L_fw:
    s_sleep 1
    ds_read_b32 v2, v3 offset:192
    s_sub_u32 s42, s42, 1
    s_cbranch_scc1 L_end
    s_waitcnt lgkmcnt(0)
    v_cmp_eq_u32 vcc, v31, v2
    s_cbranch_vccnz L_fw
    s_mov_b32 exec_hi, 0
    global_load_dwordx2 v[32:33], v4, s[38:39] sc1
    s_waitcnt vmcnt(0)
    v_cmp_eq_u32 vcc, s11, v33
    v_cmp_ne_u32 s[46:47], 0, v32
    s_mov_b32 exec_hi, -1
    s_bcnt1_i32_b32 s8, vcc_lo
    s_and_b32 s9, vcc_lo, s46
    s_bcnt1_i32_b32 s9, s9
    s_lshl_b32 s9, s9, 1
    s_cmp_gt_u32 s9, s8
    s_cselect_b32 s8, 0x2000, 0
    v_add_u32 v5, s8, v5
Lspin_8:
    ds_read_b32 v2, v3 offset:20
    s_sub_u32 s42, s42, 1
    s_cbranch_scc1 L_end
    s_waitcnt lgkmcnt(0)
    v_cmp_gt_u32 vcc, 1, v2
    s_cbranch_vccnz Lspin_8
L_Yp_loop:
    global_load_dwordx4 v[16:19], v5, s[36:37] sc1
    s_sub_u32 s42, s42, 1
    s_cbranch_scc1 L_end
    s_waitcnt vmcnt(0)
    v_perm_b32 v2, v17, v16, s44
    v_perm_b32 v4, v19, v18, s45
    v_or_b32 v2, v2, v4
    v_cmp_ne_u32 vcc, s11, v2
    s_mov_b64 exec, vcc
    s_cbranch_vccnz L_Yp_loop
    s_mov_b64 exec, -1
    v_permlane16_swap_b32 v16, v17
    v_permlane16_swap_b32 v18, v19
    v_and_b32 v16, s48, v16
    v_and_b32 v17, s48, v17
    v_and_b32 v18, s48, v18
    v_and_b32 v19, s48, v19
    v_add_f32 v16, v16, v17
    v_add_f32 v18, v18, v19
    s_nop 0
    v_add_f32_dpp v16, v16, v16 row_ror:8 row_mask:0xf bank_mask:0xf
    v_add_f32_dpp v18, v18, v18 row_ror:8 row_mask:0xf bank_mask:0xf
    s_nop 0
    v_add_f32_dpp v16, v16, v16 row_ror:4 row_mask:0xf bank_mask:0xf
    v_add_f32_dpp v18, v18, v18 row_ror:4 row_mask:0xf bank_mask:0xf
    s_nop 0
    v_add_f32_dpp v16, v16, v16 row_ror:2 row_mask:0xf bank_mask:0xf
    v_add_f32_dpp v18, v18, v18 row_ror:2 row_mask:0xf bank_mask:0xf
    s_nop 0
    v_add_f32_dpp v16, v16, v16 row_ror:1 row_mask:0xf bank_mask:0xf
    v_add_f32_dpp v18, v18, v18 row_ror:1 row_mask:0xf bank_mask:0xf
    v_cvt_pk_bf16_f32 v16, v16, v18
    v_lshlrev_b32 v17, 16, v16
    v_and_b32 v18, 0xffff0000, v16
    v_mul_f32 v17, v28, v17
    v_mul_f32 v18, v28, v18
    v_cvt_pk_bf16_f32 v16, v17, v18
    v_cvt_pk_bf16_f32 v17, v17, v18
    s_nop 1
    v_permlane32_swap_b32 v16, v17
    v_lshlrev_b32 v18, 16, v16
    v_and_b32 v19, 0xffff0000, v16
    v_lshlrev_b32 v20, 16, v17
    v_and_b32 v21, 0xffff0000, v17
    v_add_f32 v18, v18, v20
    v_add_f32 v19, v19, v21
    v_cvt_pk_bf16_f32 v16, v18, v19
    s_mov_b64 exec, 0x10001
    global_store_short v30, v16, s[26:27]
    global_store_short_d16_hi v30, v16, s[26:27] offset:4
    s_cmp_lg_u32 s2, 0
    s_cbranch_scc1 L_end
    v_mov_b32 v2, s11
    global_store_dword v3, v2, s[30:31]
    s_endpgm
L_probe:
    s_and_b32 s9, s2, 31
    s_lshl_b32 s9, s9, 14
    s_lshr_b32 s8, s2, 5
    s_lshl_b32 s22, s8, 10
    s_add_u32 s9, s9, s22
    s_lshr_b32 s8, s2, 3
    s_xor_b32 s62, s8, s4
    s_and_b32 s62, s62, 1
    s_lshl_b32 s62, s62, 13
    s_xor_b32 s63, s62, 0x2000
    s_add_u32 s9, s9, 1572864
    s_add_u32 s38, s30, s9
    s_addc_u32 s39, s31, 0
    s_getreg_b32 s9, hwreg(HW_REG_XCC_ID, 0, 3)
    s_lshl_b32 s9, s9, 5
    s_add_u32 s8, s8, s9
    s_lshl_b32 s8, s8, 3
    s_add_u32 s8, s8, 1114112
    s_add_u32 s40, s30, s8
    s_addc_u32 s41, s31, 0
    s_mov_b32 s60, -1
    s_mov_b32 s61, -1
    s_mov_b32 s54, 3
    v_mov_b32 v17, s11
    s_mov_b64 exec, 1
L_probe_loop:
    s_memtime s[56:57]
    s_branch L_stubskip_7
L_stub_7:
    s_branch L_touch_ret2
L_stubskip_7:
    s_load_dword s55, s[38:39], s62
    s_waitcnt lgkmcnt(0)
    s_memtime s[58:59]
    s_waitcnt lgkmcnt(0)
    s_sub_u32 s56, s58, s56
    s_min_u32 s60, s60, s56
    s_memtime s[56:57]
    s_load_dword s55, s[38:39], s63
    s_waitcnt lgkmcnt(0)
    s_memtime s[58:59]
    s_waitcnt lgkmcnt(0)
    s_sub_u32 s56, s58, s56
    s_min_u32 s61, s61, s56
    s_add_u32 s38, s38, 128
    s_addc_u32 s39, s39, 0
    s_cmp_lt_u32 s61, s60
    s_cselect_b32 s8, s63, s62
    v_mov_b32 v16, s8
    ds_read_b32 v2, v3 offset:56
    global_store_dwordx2 v3, v[16:17], s[40:41]
    s_waitcnt lgkmcnt(0)
    v_cmp_lt_u32 vcc, 0, v2
    s_cbranch_vccnz L_end
    s_memtime s[56:57]
    s_load_dword s55, s[38:39], s63
    s_waitcnt lgkmcnt(0)
    s_memtime s[58:59]
    s_waitcnt lgkmcnt(0)
    s_sub_u32 s56, s58, s56
    s_min_u32 s61, s61, s56
    s_memtime s[56:57]
    s_load_dword s55, s[38:39], s62
    s_waitcnt lgkmcnt(0)
    s_memtime s[58:59]
    s_waitcnt lgkmcnt(0)
    s_sub_u32 s56, s58, s56
    s_min_u32 s60, s60, s56
    s_add_u32 s38, s38, 128
    s_addc_u32 s39, s39, 0
    s_cmp_lt_u32 s61, s60
    s_cselect_b32 s8, s63, s62
    v_mov_b32 v16, s8
    ds_read_b32 v2, v3 offset:56
    global_store_dwordx2 v3, v[16:17], s[40:41]
    s_waitcnt lgkmcnt(0)
    v_cmp_lt_u32 vcc, 0, v2
    s_cbranch_vccnz L_end
    s_sub_u32 s54, s54, 1
    s_cbranch_scc0 L_probe_loop
    s_endpgm
L_Wnl:
    s_lshl_b32 s8, s3, 11
    s_add_u32 s8, s8, 1048576
    s_add_u32 s40, s30, s8
    s_addc_u32 s41, s31, 0
    v_and_b32 v12, 15, v1
    v_lshlrev_b32 v12, 7, v12
L_Wnl_loop:
    global_load_dword v2, v12, s[40:41] offset:64 sc1
    s_sub_u32 s42, s42, 1
    s_cbranch_scc1 L_end
    s_waitcnt vmcnt(0)
    v_cmp_ne_u32 vcc, s11, v2
    s_cbranch_vccnz L_Wnl_loop
    s_branch L_Wloc
L_Knl:
    global_store_dwordx4 v6, v[32:35], s[36:37] sc1
    s_branch L_Kpost
L_Kend:
    s_cmp_eq_u32 s43, 0
    s_cbranch_scc1 L_end
L_repub:
    s_cmp_lg_u32 s6, 2
    s_cbranch_scc1 L_repub_ret
Lspin_7:
    ds_read_b32 v2, v3 offset:52
    s_sub_u32 s42, s42, 1
    s_cbranch_scc1 L_end
    s_waitcnt lgkmcnt(0)
    v_cmp_gt_u32 vcc, 1, v2
    s_cbranch_vccnz Lspin_7
    s_lshl_b32 s8, s10, 9
    s_add_u32 s8, s8, 65536
    s_add_u32 s38, s30, s8
    s_addc_u32 s39, s31, 0
    s_mov_b32 exec_hi, 0
    ds_read_b128 v[104:107], v6 offset:1536
    s_waitcnt lgkmcnt(0)
    global_store_dwordx4 v6, v[104:107], s[38:39] sc1
    s_mov_b32 exec_hi, -1
L_repub_ret:
    s_cmp_eq_u32 s43, 0
    s_cbranch_scc1 L_c2
    s_endpgm
L_Vnl:
    global_store_dwordx4 v4, v[8:11], s[36:37] sc1
    ds_write_b32 v3, v7 offset:56
    s_add_u32 s11, s11, 0x9E3779B9
    s_lshl_b32 s8, s10, 7
    s_add_u32 s8, s8, 1048576
    s_add_u32 s38, s30, s8
    s_addc_u32 s39, s31, 0
    v_mov_b32 v2, s11
    s_mov_b64 exec, 1
    s_waitcnt vmcnt(0)
    global_store_dword v3, v2, s[38:39] offset:64 sc1
    s_endpgm
L_end:
    s_endpgm
.section .rodata,"a"
.p2align 6
.amdhsa_kernel gated_mix__sliding_block_cached__sliding_block_cached__decode_kernel
  .amdhsa_next_free_vgpr 152
  .amdhsa_next_free_sgpr 96
  .amdhsa_accum_offset 152
  .amdhsa_group_segment_fixed_size 0
  .amdhsa_kernarg_size 112
  .amdhsa_user_sgpr_count 2
  .amdhsa_user_sgpr_kernarg_segment_ptr 1
  .amdhsa_system_sgpr_workgroup_id_x 1
.end_amdhsa_kernel
```
